```python
import torch

def _softmax(x, axis=-1):
    return torch.softmax(x, dim=axis)
def _gelu(x):
    return torch.nn.functional.gelu(x, approximate="tanh")
def _silu(x):
    return torch.nn.functional.silu(x)
def _sigmoid(x):
    return torch.sigmoid(x)
def _layernorm(x, axis=-1, eps=1e-5):
    m = x.mean(dim=axis, keepdim=True)
    v = x.var(dim=axis, keepdim=True, unbiased=False)
    return (x - m) / torch.sqrt(v + eps)
def _scatter_add(tgt, idx, src, axis=0):
    return tgt.clone().index_add_(axis, idx, src)
def _segment_sum(src, seg, n):
    out = torch.zeros((n,) + src.shape[1:], dtype=src.dtype)
    return out.index_add_(0, seg, src)
def _pad(x, pw):
    flat = tuple(v for pair in reversed(pw) for v in pair)
    return torch.nn.functional.pad(x, flat)

kernel_name = 'standalone__softmax_full_bidir__decode'

def setup_inputs():

    _w = (lambda a: (lambda t: t.to(torch.bfloat16) if t.is_floating_point() else t)(torch.as_tensor(a)))
    B, H, Sq, Skv, Dh = 4, 32, 1, 4096, 192
    return {
        "q": _w((lambda *s: torch.randn(*s, dtype=torch.bfloat16) * 0.8)(B, H, Sq, Dh)),
        "k": _w((lambda *s: torch.randn(*s, dtype=torch.bfloat16) * 0.8)(B, H, Skv, Dh)),
        "v": _w((lambda *s: torch.randn(*s, dtype=torch.bfloat16) * 0.05)(B, H, Skv, Dh)),
    }

def reference(q, k, v):
    scale = q.shape[-1] ** -0.5
    scores = torch.einsum('bhqd,bhkd->bhqk', q, k) * scale
    attn = _softmax(scores, axis=-1)
    return torch.einsum('bhqk,bhkd->bhqd', attn, v)
```

```asm
; @launch grid=(256,1,1) block=(256,1,1) lds=84000
.amdgcn_target "amdgcn-amd-amdhsa--gfx950"
.text
.globl standalone__softmax_full_bidir__decode_kernel
.p2align 8
.type standalone__softmax_full_bidir__decode_kernel,@function
standalone__softmax_full_bidir__decode_kernel:
  s_cmp_ge_u32 s2, 256
  s_cbranch_scc1 L_end
  s_load_dwordx2 s[8:9], s[0:1], 8
  s_load_dwordx2 s[16:17], s[0:1], 0
  s_load_dwordx2 s[12:13], s[0:1], 16
  s_load_dwordx2 s[20:21], s[0:1], 24
  s_load_dwordx2 s[24:25], s[0:1], 32
  s_load_dwordx2 s[28:29], s[0:1], 40
  v_lshrrev_b32 v3, 6, v0
  v_and_b32 v2, 63, v0
  v_readfirstlane_b32 s32, v3
  v_lshrrev_b32 v4, 3, v2
  v_lshlrev_b32 v92, 2, v4
  v_mul_u32_u24 v4, 384, v4
  v_and_b32 v5, 7, v2
  v_lshlrev_b32 v6, 4, v5
  v_add_u32 v1, v4, v6
  s_lshr_b32 s33, s2, 3
  s_lshl_b32 s33, s33, 2
  s_and_b32 s44, s2, 3
  s_or_b32 s33, s33, s44
  s_bfe_u32 s34, s2, 0x10002
  s_mov_b32 s10, 0xc000000
  s_mov_b32 s11, 0x20000
  s_mov_b32 s14, 0xc000000
  s_mov_b32 s15, 0x20000
  s_mov_b32 s18, 0xc000
  s_mov_b32 s19, 0x20000
  s_mov_b32 s22, 0xc000
  s_mov_b32 s23, 0x20000
  s_mov_b32 s26, 0x100
  s_mov_b32 s27, 0x20000
  s_mov_b32 s30, 0x30000000
  s_mov_b32 s31, 0x20000
  s_mul_i32 s36, s33, 1572864
  s_mul_i32 s37, s33, 1
  s_and_b32 s37, s37, 63
  s_lshl_b32 s37, s37, 3
  s_lshl_b32 s35, s34, 3
  s_add_u32 s42, s35, s37
  s_lshr_b32 s44, s32, 3
  s_lshl_b32 s44, s44, 4
  s_and_b32 s39, s32, 7
  s_add_u32 s44, s44, s39
  s_add_u32 s44, s44, s42
  s_and_b32 s44, s44, 511
  s_mul_i32 s44, s44, 3072
  s_add_u32 s39, s44, s36
  s_mov_b32 s43, s39
  s_add_u32 s41, s32, 4
  s_lshr_b32 s44, s41, 3
  s_lshl_b32 s44, s44, 4
  s_and_b32 s39, s41, 7
  s_add_u32 s44, s44, s39
  s_add_u32 s44, s44, s42
  s_and_b32 s44, s44, 511
  s_mul_i32 s44, s44, 3072
  s_add_u32 s39, s44, s36
  s_lshl_b32 s46, s32, 5
  s_lshl_b32 s47, s41, 5
  s_mul_i32 s45, s33, 384
  s_lshl_b32 s50, s33, 11
  s_lshl_b32 s44, s34, 10
  s_add_u32 s50, s50, s44
  s_xor_b32 s51, s50, 1024
  v_lshlrev_b32 v10, 4, v2
  s_waitcnt lgkmcnt(0)
  buffer_load_dwordx4 v[64:67], v1, s[8:11], s43 offen offset:0 nt
  buffer_load_dwordx4 v[68:71], v1, s[8:11], s43 offen offset:128 nt
  buffer_load_dwordx4 v[72:75], v1, s[8:11], s43 offen offset:256 nt
  buffer_load_dwordx4 v[40:43], v6, s[16:19], s45 offen offset:0
  buffer_load_dwordx4 v[44:47], v6, s[16:19], s45 offen offset:128
  buffer_load_dwordx4 v[48:51], v6, s[16:19], s45 offen offset:256
  buffer_load_dwordx4 v[76:79], v1, s[8:11], s39 offen offset:0 nt
  buffer_load_dwordx4 v[80:83], v1, s[8:11], s39 offen offset:128 nt
  buffer_load_dwordx4 v[84:87], v1, s[8:11], s39 offen offset:256 nt
  v_mov_b32 v15, 8
  v_mov_b32 v59, 14592
  s_cmp_lg_u32 s32, 0
  s_cbranch_scc1 L_noinit
  buffer_load_dwordx4 v[60:63], v10, s[28:31], s50 offen sc1
  ds_write_b32 v59, v15
  s_waitcnt lgkmcnt(0)
L_noinit:
  s_barrier
  v_mov_b32 v16, 0
  v_mov_b32 v17, 0
  v_mov_b32 v18, 0
  v_mov_b32 v19, 0
  v_and_b32 v3, 1, v5
  v_lshlrev_b32 v3, 4, v3
  v_mov_b32 v4, 0xffff
  v_lshlrev_b32 v4, v3, v4
  v_lshrrev_b32 v3, 1, v5
  v_cmp_eq_u32 vcc, 0, v3
  v_mov_b32 v20, 0x3f803f80
  s_nop 0
  v_cndmask_b32 v16, v16, v4, vcc
  v_cmp_eq_u32 vcc, 1, v3
  v_mov_b32 v21, 0x3f803f80
  s_nop 0
  v_cndmask_b32 v17, v17, v4, vcc
  v_cmp_eq_u32 vcc, 2, v3
  v_mov_b32 v22, 0x3f803f80
  s_nop 0
  v_cndmask_b32 v18, v18, v4, vcc
  v_cmp_eq_u32 vcc, 3, v3
  v_mov_b32 v23, 0x3f803f80
  s_nop 0
  v_cndmask_b32 v19, v19, v4, vcc
  v_mov_b32 v24, 0
  v_mov_b32 v25, 0
  v_mov_b32 v26, 0
  v_mov_b32 v27, 0
  v_mov_b32 v28, 0
  v_mov_b32 v29, 0
  v_mov_b32 v30, 0
  v_mov_b32 v31, 0
  v_mov_b32 v32, 0
  v_mov_b32 v33, 0
  v_mov_b32 v34, 0
  v_mov_b32 v35, 0
  v_mov_b32 v36, 0
  v_mov_b32 v37, 0
  v_mov_b32 v38, 0
  v_mov_b32 v39, 0
  v_mov_b32 v7, 0xff7fffff
  s_mov_b32 s40, 0x3dd53b95
  v_cmp_eq_u32 s[48:49], 0, v5
  s_mul_i32 s43, s32, 1600
  s_add_u32 s43, s43, 8192
  v_and_b32 v4, 15, v2
  v_lshrrev_b32 v5, 4, v2
  v_lshrrev_b32 v6, 3, v4
  v_lshrrev_b32 v3, 1, v5
  v_cmp_eq_u32 s[56:57], v6, v3
  v_mul_u32_u24 v11, 800, v6
  v_and_b32 v4, 7, v4
  v_lshlrev_b32 v4, 5, v4
  v_and_b32 v5, 1, v5
  v_lshlrev_b32 v5, 4, v5
  v_add3_u32 v10, v11, v4, v5
  v_add_u32 v10, s43, v10
  v_add_u32 v11, s43, v11
L_k_A:
  v_mov_b32 v15, 1
  s_mov_b64 exec, 1
  ds_add_rtn_u32 v15, v59, v15
  s_mov_b64 exec, -1
  s_waitcnt vmcnt(3)
  v_dot2_f32_bf16 v56, v64, v40, 0
  v_dot2_f32_bf16 v56, v65, v41, v56
  v_dot2_f32_bf16 v56, v66, v42, v56
  v_dot2_f32_bf16 v56, v67, v43, v56
  v_dot2_f32_bf16 v57, v68, v44, 0
  v_dot2_f32_bf16 v57, v69, v45, v57
  v_dot2_f32_bf16 v57, v70, v46, v57
  v_dot2_f32_bf16 v57, v71, v47, v57
  v_dot2_f32_bf16 v58, v72, v48, 0
  v_dot2_f32_bf16 v58, v73, v49, v58
  v_dot2_f32_bf16 v58, v74, v50, v58
  v_dot2_f32_bf16 v58, v75, v51, v58
  s_waitcnt lgkmcnt(0)
  v_readfirstlane_b32 s41, v15
  s_nop 3
  s_cmp_ge_u32 s41, 256
  s_cbranch_scc1 L_tr_A
  s_lshr_b32 s44, s41, 3
  s_lshl_b32 s44, s44, 4
  s_and_b32 s39, s41, 7
  s_add_u32 s44, s44, s39
  s_add_u32 s44, s44, s42
  s_and_b32 s44, s44, 511
  s_mul_i32 s44, s44, 3072
  s_add_u32 s39, s44, s36
  buffer_load_dwordx4 v[64:67], v1, s[8:11], s39 offen offset:0 nt
  buffer_load_dwordx4 v[68:71], v1, s[8:11], s39 offen offset:128 nt
  buffer_load_dwordx4 v[72:75], v1, s[8:11], s39 offen offset:256 nt
  s_nop 2
  v_add_f32 v57, v57, v58
  v_add_f32 v56, v56, v57
  s_nop 1
  v_add_f32_dpp v56, v56, v56 quad_perm:[1,0,3,2] row_mask:0xf bank_mask:0xf
  s_nop 1
  v_add_f32_dpp v56, v56, v56 quad_perm:[2,3,0,1] row_mask:0xf bank_mask:0xf
  s_nop 1
  v_add_f32_dpp v56, v56, v56 row_half_mirror row_mask:0xf bank_mask:0xf
  v_add_u32 v3, s46, v92
  v_max_f32 v7, v7, v56
  s_mov_b64 exec, s[48:49]
  ds_write_b32 v3, v56 offset:0
  s_mov_b64 exec, -1
  s_lshl_b32 s46, s41, 5
L_k_B:
  v_mov_b32 v15, 1
  s_mov_b64 exec, 1
  ds_add_rtn_u32 v15, v59, v15
  s_mov_b64 exec, -1
  s_waitcnt vmcnt(3)
  v_dot2_f32_bf16 v56, v76, v40, 0
  v_dot2_f32_bf16 v56, v77, v41, v56
  v_dot2_f32_bf16 v56, v78, v42, v56
  v_dot2_f32_bf16 v56, v79, v43, v56
  v_dot2_f32_bf16 v57, v80, v44, 0
  v_dot2_f32_bf16 v57, v81, v45, v57
  v_dot2_f32_bf16 v57, v82, v46, v57
  v_dot2_f32_bf16 v57, v83, v47, v57
  v_dot2_f32_bf16 v58, v84, v48, 0
  v_dot2_f32_bf16 v58, v85, v49, v58
  v_dot2_f32_bf16 v58, v86, v50, v58
  v_dot2_f32_bf16 v58, v87, v51, v58
  s_waitcnt lgkmcnt(0)
  v_readfirstlane_b32 s41, v15
  s_nop 3
  s_cmp_ge_u32 s41, 256
  s_cbranch_scc1 L_tr_B
  s_lshr_b32 s44, s41, 3
  s_lshl_b32 s44, s44, 4
  s_and_b32 s39, s41, 7
  s_add_u32 s44, s44, s39
  s_add_u32 s44, s44, s42
  s_and_b32 s44, s44, 511
  s_mul_i32 s44, s44, 3072
  s_add_u32 s39, s44, s36
  buffer_load_dwordx4 v[76:79], v1, s[8:11], s39 offen offset:0 nt
  buffer_load_dwordx4 v[80:83], v1, s[8:11], s39 offen offset:128 nt
  buffer_load_dwordx4 v[84:87], v1, s[8:11], s39 offen offset:256 nt
  s_nop 2
  v_add_f32 v57, v57, v58
  v_add_f32 v56, v56, v57
  s_nop 1
  v_add_f32_dpp v56, v56, v56 quad_perm:[1,0,3,2] row_mask:0xf bank_mask:0xf
  s_nop 1
  v_add_f32_dpp v56, v56, v56 quad_perm:[2,3,0,1] row_mask:0xf bank_mask:0xf
  s_nop 1
  v_add_f32_dpp v56, v56, v56 row_half_mirror row_mask:0xf bank_mask:0xf
  v_add_u32 v3, s47, v92
  v_max_f32 v7, v7, v56
  s_mov_b64 exec, s[48:49]
  ds_write_b32 v3, v56 offset:0
  s_mov_b64 exec, -1
  s_lshl_b32 s47, s41, 5
  s_branch L_k_A
L_tr_A:
  s_sub_u32 s41, s41, 256
  s_lshr_b32 s44, s41, 3
  s_lshl_b32 s44, s44, 4
  s_and_b32 s39, s41, 7
  s_add_u32 s44, s44, s39
  s_add_u32 s44, s44, s42
  s_and_b32 s44, s44, 511
  s_mul_i32 s44, s44, 3072
  s_add_u32 s39, s44, s36
  buffer_load_dwordx4 v[64:67], v1, s[12:15], s39 offen offset:0 nt
  buffer_load_dwordx4 v[68:71], v1, s[12:15], s39 offen offset:128 nt
  buffer_load_dwordx4 v[72:75], v1, s[12:15], s39 offen offset:256 nt
  s_nop 2
  v_add_f32 v57, v57, v58
  v_add_f32 v56, v56, v57
  s_nop 1
  v_add_f32_dpp v56, v56, v56 quad_perm:[1,0,3,2] row_mask:0xf bank_mask:0xf
  s_nop 1
  v_add_f32_dpp v56, v56, v56 quad_perm:[2,3,0,1] row_mask:0xf bank_mask:0xf
  s_nop 1
  v_add_f32_dpp v56, v56, v56 row_half_mirror row_mask:0xf bank_mask:0xf
  v_add_u32 v3, s46, v92
  v_max_f32 v7, v7, v56
  s_mov_b64 exec, s[48:49]
  ds_write_b32 v3, v56 offset:0
  s_mov_b64 exec, -1
  s_lshl_b32 s46, s41, 5
  v_mov_b32 v15, 1
  s_mov_b64 exec, 1
  ds_add_rtn_u32 v15, v59, v15
  s_mov_b64 exec, -1
  s_waitcnt vmcnt(3)
  v_dot2_f32_bf16 v56, v76, v40, 0
  v_dot2_f32_bf16 v56, v77, v41, v56
  v_dot2_f32_bf16 v56, v78, v42, v56
  v_dot2_f32_bf16 v56, v79, v43, v56
  v_dot2_f32_bf16 v57, v80, v44, 0
  v_dot2_f32_bf16 v57, v81, v45, v57
  v_dot2_f32_bf16 v57, v82, v46, v57
  v_dot2_f32_bf16 v57, v83, v47, v57
  v_dot2_f32_bf16 v58, v84, v48, 0
  v_dot2_f32_bf16 v58, v85, v49, v58
  v_dot2_f32_bf16 v58, v86, v50, v58
  v_dot2_f32_bf16 v58, v87, v51, v58
  s_waitcnt lgkmcnt(0)
  v_readfirstlane_b32 s41, v15
  s_nop 3
  s_sub_u32 s41, s41, 256
  s_lshr_b32 s44, s41, 3
  s_lshl_b32 s44, s44, 4
  s_and_b32 s39, s41, 7
  s_add_u32 s44, s44, s39
  s_add_u32 s44, s44, s42
  s_and_b32 s44, s44, 511
  s_mul_i32 s44, s44, 3072
  s_add_u32 s39, s44, s36
  buffer_load_dwordx4 v[76:79], v1, s[12:15], s39 offen offset:0 nt
  buffer_load_dwordx4 v[80:83], v1, s[12:15], s39 offen offset:128 nt
  buffer_load_dwordx4 v[84:87], v1, s[12:15], s39 offen offset:256 nt
  s_nop 2
  v_add_f32 v57, v57, v58
  v_add_f32 v56, v56, v57
  s_nop 1
  v_add_f32_dpp v56, v56, v56 quad_perm:[1,0,3,2] row_mask:0xf bank_mask:0xf
  s_nop 1
  v_add_f32_dpp v56, v56, v56 quad_perm:[2,3,0,1] row_mask:0xf bank_mask:0xf
  s_nop 1
  v_add_f32_dpp v56, v56, v56 row_half_mirror row_mask:0xf bank_mask:0xf
  v_add_u32 v3, s47, v92
  v_max_f32 v7, v7, v56
  s_mov_b64 exec, s[48:49]
  ds_write_b32 v3, v56 offset:0
  s_mov_b64 exec, -1
  s_lshl_b32 s47, s41, 5
  s_mov_b32 s55, 0
  s_branch L_mid
L_tr_B:
  s_sub_u32 s41, s41, 256
  s_lshr_b32 s44, s41, 3
  s_lshl_b32 s44, s44, 4
  s_and_b32 s39, s41, 7
  s_add_u32 s44, s44, s39
  s_add_u32 s44, s44, s42
  s_and_b32 s44, s44, 511
  s_mul_i32 s44, s44, 3072
  s_add_u32 s39, s44, s36
  buffer_load_dwordx4 v[76:79], v1, s[12:15], s39 offen offset:0 nt
  buffer_load_dwordx4 v[80:83], v1, s[12:15], s39 offen offset:128 nt
  buffer_load_dwordx4 v[84:87], v1, s[12:15], s39 offen offset:256 nt
  s_nop 2
  v_add_f32 v57, v57, v58
  v_add_f32 v56, v56, v57
  s_nop 1
  v_add_f32_dpp v56, v56, v56 quad_perm:[1,0,3,2] row_mask:0xf bank_mask:0xf
  s_nop 1
  v_add_f32_dpp v56, v56, v56 quad_perm:[2,3,0,1] row_mask:0xf bank_mask:0xf
  s_nop 1
  v_add_f32_dpp v56, v56, v56 row_half_mirror row_mask:0xf bank_mask:0xf
  v_add_u32 v3, s47, v92
  v_max_f32 v7, v7, v56
  s_mov_b64 exec, s[48:49]
  ds_write_b32 v3, v56 offset:0
  s_mov_b64 exec, -1
  s_lshl_b32 s47, s41, 5
  v_mov_b32 v15, 1
  s_mov_b64 exec, 1
  ds_add_rtn_u32 v15, v59, v15
  s_mov_b64 exec, -1
  s_waitcnt vmcnt(3)
  v_dot2_f32_bf16 v56, v64, v40, 0
  v_dot2_f32_bf16 v56, v65, v41, v56
  v_dot2_f32_bf16 v56, v66, v42, v56
  v_dot2_f32_bf16 v56, v67, v43, v56
  v_dot2_f32_bf16 v57, v68, v44, 0
  v_dot2_f32_bf16 v57, v69, v45, v57
  v_dot2_f32_bf16 v57, v70, v46, v57
  v_dot2_f32_bf16 v57, v71, v47, v57
  v_dot2_f32_bf16 v58, v72, v48, 0
  v_dot2_f32_bf16 v58, v73, v49, v58
  v_dot2_f32_bf16 v58, v74, v50, v58
  v_dot2_f32_bf16 v58, v75, v51, v58
  s_waitcnt lgkmcnt(0)
  v_readfirstlane_b32 s41, v15
  s_nop 3
  s_sub_u32 s41, s41, 256
  s_lshr_b32 s44, s41, 3
  s_lshl_b32 s44, s44, 4
  s_and_b32 s39, s41, 7
  s_add_u32 s44, s44, s39
  s_add_u32 s44, s44, s42
  s_and_b32 s44, s44, 511
  s_mul_i32 s44, s44, 3072
  s_add_u32 s39, s44, s36
  buffer_load_dwordx4 v[64:67], v1, s[12:15], s39 offen offset:0 nt
  buffer_load_dwordx4 v[68:71], v1, s[12:15], s39 offen offset:128 nt
  buffer_load_dwordx4 v[72:75], v1, s[12:15], s39 offen offset:256 nt
  s_nop 2
  v_add_f32 v57, v57, v58
  v_add_f32 v56, v56, v57
  s_nop 1
  v_add_f32_dpp v56, v56, v56 quad_perm:[1,0,3,2] row_mask:0xf bank_mask:0xf
  s_nop 1
  v_add_f32_dpp v56, v56, v56 quad_perm:[2,3,0,1] row_mask:0xf bank_mask:0xf
  s_nop 1
  v_add_f32_dpp v56, v56, v56 row_half_mirror row_mask:0xf bank_mask:0xf
  v_add_u32 v3, s46, v92
  v_max_f32 v7, v7, v56
  s_mov_b64 exec, s[48:49]
  ds_write_b32 v3, v56 offset:0
  s_mov_b64 exec, -1
  s_lshl_b32 s46, s41, 5
  s_mov_b32 s55, 1
L_mid:
  s_nop 1
  v_max_f32_dpp v7, v7, v7 row_ror:8 row_mask:0xf bank_mask:0xf
  v_mov_b32 v4, v7
  s_nop 1
  v_permlane16_swap_b32 v7, v4
  v_max_f32 v7, v7, v4
  v_mov_b32 v4, v7
  s_nop 1
  v_permlane32_swap_b32 v7, v4
  v_max_f32 v7, v7, v4
  s_lshl_b32 s44, s32, 2
  v_mov_b32 v3, s44
  ds_write_b32 v3, v7 offset:14608
  s_waitcnt lgkmcnt(0)
  s_barrier
  v_mov_b32 v3, 0
  ds_read_b32 v56, v3 offset:14608
  ds_read_b32 v57, v3 offset:14612
  ds_read_b32 v58, v3 offset:14616
  ds_read_b32 v5, v3 offset:14620
  s_waitcnt lgkmcnt(0)
  v_max_f32 v7, v56, v57
  v_max_f32 v7, v7, v58
  v_max_f32 v7, v7, v5
  v_mul_f32 v9, s40, v7
  v_add_u32 v3, s46, v92
  ds_read_b32 v56, v3 offset:0
  s_waitcnt lgkmcnt(0)
  v_fma_f32 v56, v56, s40, -v9
  v_exp_f32 v56, v56
  s_nop 0
  v_cvt_pk_bf16_f32 v57, v56, v56
  v_and_b32 v52, v57, v16
  v_and_b32 v53, v57, v17
  v_and_b32 v54, v57, v18
  v_and_b32 v55, v57, v19
  v_add_u32 v3, s47, v92
  ds_read_b32 v56, v3 offset:0
  s_waitcnt lgkmcnt(0)
  v_fma_f32 v56, v56, s40, -v9
  v_exp_f32 v56, v56
  s_nop 0
  v_cvt_pk_bf16_f32 v57, v56, v56
  v_and_b32 v88, v57, v16
  v_and_b32 v89, v57, v17
  v_and_b32 v90, v57, v18
  v_and_b32 v91, v57, v19
  s_cmp_eq_u32 s55, 1
  s_cbranch_scc1 L_v_B
L_v_A:
  v_mov_b32 v15, 1
  s_mov_b64 exec, 1
  ds_add_rtn_u32 v15, v59, v15
  s_mov_b64 exec, -1
  s_waitcnt vmcnt(3)
  v_mfma_f32_16x16x32_bf16 v[24:27], v[52:55], v[64:67], v[24:27]
  v_mfma_f32_16x16x32_bf16 v[28:31], v[52:55], v[68:71], v[28:31]
  v_mfma_f32_16x16x32_bf16 v[32:35], v[52:55], v[72:75], v[32:35]
  v_mfma_f32_16x16x32_bf16 v[36:39], v[52:55], v[20:23], v[36:39]
  s_waitcnt lgkmcnt(0)
  v_readfirstlane_b32 s41, v15
  s_nop 3
  s_cmp_ge_u32 s41, 500
  s_cbranch_scc1 L_fin_A
  s_sub_u32 s41, s41, 256
  s_lshr_b32 s44, s41, 3
  s_lshl_b32 s44, s44, 4
  s_and_b32 s39, s41, 7
  s_add_u32 s44, s44, s39
  s_add_u32 s44, s44, s42
  s_and_b32 s44, s44, 511
  s_mul_i32 s44, s44, 3072
  s_add_u32 s39, s44, s36
  buffer_load_dwordx4 v[64:67], v1, s[12:15], s39 offen offset:0 nt
  buffer_load_dwordx4 v[68:71], v1, s[12:15], s39 offen offset:128 nt
  buffer_load_dwordx4 v[72:75], v1, s[12:15], s39 offen offset:256 nt
  s_lshl_b32 s46, s41, 5
  v_add_u32 v3, s46, v92
  ds_read_b32 v56, v3 offset:0
  s_waitcnt lgkmcnt(0)
  v_fma_f32 v56, v56, s40, -v9
  v_exp_f32 v56, v56
  s_nop 0
  v_cvt_pk_bf16_f32 v57, v56, v56
  v_and_b32 v52, v57, v16
  v_and_b32 v53, v57, v17
  v_and_b32 v54, v57, v18
  v_and_b32 v55, v57, v19
L_v_B:
  v_mov_b32 v15, 1
  s_mov_b64 exec, 1
  ds_add_rtn_u32 v15, v59, v15
  s_mov_b64 exec, -1
  s_waitcnt vmcnt(3)
  v_mfma_f32_16x16x32_bf16 v[24:27], v[88:91], v[76:79], v[24:27]
  v_mfma_f32_16x16x32_bf16 v[28:31], v[88:91], v[80:83], v[28:31]
  v_mfma_f32_16x16x32_bf16 v[32:35], v[88:91], v[84:87], v[32:35]
  v_mfma_f32_16x16x32_bf16 v[36:39], v[88:91], v[20:23], v[36:39]
  s_waitcnt lgkmcnt(0)
  v_readfirstlane_b32 s41, v15
  s_nop 3
  s_cmp_ge_u32 s41, 500
  s_cbranch_scc1 L_fin_B
  s_sub_u32 s41, s41, 256
  s_lshr_b32 s44, s41, 3
  s_lshl_b32 s44, s44, 4
  s_and_b32 s39, s41, 7
  s_add_u32 s44, s44, s39
  s_add_u32 s44, s44, s42
  s_and_b32 s44, s44, 511
  s_mul_i32 s44, s44, 3072
  s_add_u32 s39, s44, s36
  buffer_load_dwordx4 v[76:79], v1, s[12:15], s39 offen offset:0 nt
  buffer_load_dwordx4 v[80:83], v1, s[12:15], s39 offen offset:128 nt
  buffer_load_dwordx4 v[84:87], v1, s[12:15], s39 offen offset:256 nt
  s_lshl_b32 s47, s41, 5
  v_add_u32 v3, s47, v92
  ds_read_b32 v56, v3 offset:0
  s_waitcnt lgkmcnt(0)
  v_fma_f32 v56, v56, s40, -v9
  v_exp_f32 v56, v56
  s_nop 0
  v_cvt_pk_bf16_f32 v57, v56, v56
  v_and_b32 v88, v57, v16
  v_and_b32 v89, v57, v17
  v_and_b32 v90, v57, v18
  v_and_b32 v91, v57, v19
  s_branch L_v_A
L_fin_A:
  s_mov_b32 s55, 1
  s_branch L_last
L_fin_B:
  s_mov_b32 s55, 0
L_last:
  v_mov_b32 v15, 2
  s_mov_b64 exec, 1
  ds_add_rtn_u32 v15, v59, v15
  s_mov_b64 exec, -1
  s_sub_u32 s41, s41, 256
  s_lshr_b32 s44, s41, 3
  s_lshl_b32 s44, s44, 4
  s_and_b32 s39, s41, 7
  s_add_u32 s44, s44, s39
  s_add_u32 s44, s44, s42
  s_and_b32 s44, s44, 511
  s_mul_i32 s44, s44, 3072
  s_add_u32 s39, s44, s36
  buffer_load_dwordx4 v[96:99], v1, s[12:15], s39 offen offset:0 nt
  buffer_load_dwordx4 v[100:103], v1, s[12:15], s39 offen offset:128 nt
  buffer_load_dwordx4 v[104:107], v1, s[12:15], s39 offen offset:256 nt
  s_lshl_b32 s53, s41, 5
  s_waitcnt lgkmcnt(0)
  v_readfirstlane_b32 s54, v15
  v_add_u32 v3, s53, v92
  ds_read_b32 v56, v3 offset:0
  s_waitcnt lgkmcnt(0)
  v_fma_f32 v56, v56, s40, -v9
  v_exp_f32 v56, v56
  s_nop 0
  v_cvt_pk_bf16_f32 v57, v56, v56
  v_and_b32 v108, v57, v16
  v_and_b32 v109, v57, v17
  v_and_b32 v110, v57, v18
  v_and_b32 v111, v57, v19
  s_sub_u32 s41, s54, 256
  s_lshr_b32 s44, s41, 3
  s_lshl_b32 s44, s44, 4
  s_and_b32 s39, s41, 7
  s_add_u32 s44, s44, s39
  s_add_u32 s44, s44, s42
  s_and_b32 s44, s44, 511
  s_mul_i32 s44, s44, 3072
  s_add_u32 s39, s44, s36
  buffer_load_dwordx4 v[112:115], v1, s[12:15], s39 offen offset:0 nt
  buffer_load_dwordx4 v[116:119], v1, s[12:15], s39 offen offset:128 nt
  buffer_load_dwordx4 v[120:123], v1, s[12:15], s39 offen offset:256 nt
  s_lshl_b32 s53, s41, 5
  v_add_u32 v3, s53, v92
  ds_read_b32 v56, v3 offset:0
  s_waitcnt lgkmcnt(0)
  v_fma_f32 v56, v56, s40, -v9
  v_exp_f32 v56, v56
  s_nop 0
  v_cvt_pk_bf16_f32 v57, v56, v56
  v_and_b32 v124, v57, v16
  v_and_b32 v125, v57, v17
  v_and_b32 v126, v57, v18
  v_and_b32 v127, v57, v19
  s_add_u32 s41, s41, 1
  s_lshr_b32 s44, s41, 3
  s_lshl_b32 s44, s44, 4
  s_and_b32 s39, s41, 7
  s_add_u32 s44, s44, s39
  s_add_u32 s44, s44, s42
  s_and_b32 s44, s44, 511
  s_mul_i32 s44, s44, 3072
  s_add_u32 s39, s44, s36
  buffer_load_dwordx4 v[128:131], v1, s[12:15], s39 offen offset:0 nt
  buffer_load_dwordx4 v[132:135], v1, s[12:15], s39 offen offset:128 nt
  buffer_load_dwordx4 v[136:139], v1, s[12:15], s39 offen offset:256 nt
  s_lshl_b32 s53, s41, 5
  v_add_u32 v3, s53, v92
  ds_read_b32 v56, v3 offset:0
  s_waitcnt lgkmcnt(0)
  v_fma_f32 v56, v56, s40, -v9
  v_exp_f32 v56, v56
  s_nop 0
  v_cvt_pk_bf16_f32 v57, v56, v56
  v_and_b32 v140, v57, v16
  v_and_b32 v141, v57, v17
  v_and_b32 v142, v57, v18
  v_and_b32 v143, v57, v19
  s_cmp_lg_u32 s32, 0
  s_cbranch_scc1 L_noann
  v_and_b32 v61, 0xff, v61
  v_and_b32 v63, 0xff, v63
  s_mov_b32 s52, 1
  v_cmp_gt_u32 s[48:49], 49, v2
L_tagloop:
  v_cmp_eq_u32 vcc, s52, v61
  v_cmp_eq_u32 s[58:59], s52, v63
  s_nop 1
  s_or_b64 vcc, vcc, s[58:59]
  s_and_b64 vcc, vcc, s[48:49]
  s_cbranch_scc0 L_tagok
  s_add_u32 s52, s52, 1
  s_branch L_tagloop
L_tagok:
  s_and_b32 s53, s33, 1
  s_lshl_b32 s53, s53, 1
  s_add_u32 s53, s53, s34
  s_lshl_b32 s53, s53, 3
  s_lshl_b32 s54, s52, s53
  s_lshr_b32 s44, s33, 1
  s_lshl_b32 s44, s44, 2
  v_mov_b32 v14, s54
  v_mov_b32 v3, s44
  s_mov_b64 exec, 1
  buffer_atomic_or v14, v3, s[24:27], 0 offen sc0 sc1
  s_mov_b64 exec, -1
L_noann:
  s_waitcnt vmcnt(9)
  s_cmp_eq_u32 s55, 1
  s_cbranch_scc1 L_lastB
  v_mfma_f32_16x16x32_bf16 v[24:27], v[52:55], v[64:67], v[24:27]
  v_mfma_f32_16x16x32_bf16 v[28:31], v[52:55], v[68:71], v[28:31]
  v_mfma_f32_16x16x32_bf16 v[32:35], v[52:55], v[72:75], v[32:35]
  v_mfma_f32_16x16x32_bf16 v[36:39], v[52:55], v[20:23], v[36:39]
  s_branch L_lastdone
L_lastB:
  v_mfma_f32_16x16x32_bf16 v[24:27], v[88:91], v[76:79], v[24:27]
  v_mfma_f32_16x16x32_bf16 v[28:31], v[88:91], v[80:83], v[28:31]
  v_mfma_f32_16x16x32_bf16 v[32:35], v[88:91], v[84:87], v[32:35]
  v_mfma_f32_16x16x32_bf16 v[36:39], v[88:91], v[20:23], v[36:39]
L_lastdone:
  s_waitcnt vmcnt(6)
  v_mfma_f32_16x16x32_bf16 v[24:27], v[108:111], v[96:99], v[24:27]
  v_mfma_f32_16x16x32_bf16 v[28:31], v[108:111], v[100:103], v[28:31]
  v_mfma_f32_16x16x32_bf16 v[32:35], v[108:111], v[104:107], v[32:35]
  v_mfma_f32_16x16x32_bf16 v[36:39], v[108:111], v[20:23], v[36:39]
  s_waitcnt vmcnt(3)
  v_mfma_f32_16x16x32_bf16 v[24:27], v[124:127], v[112:115], v[24:27]
  v_mfma_f32_16x16x32_bf16 v[28:31], v[124:127], v[116:119], v[28:31]
  v_mfma_f32_16x16x32_bf16 v[32:35], v[124:127], v[120:123], v[32:35]
  v_mfma_f32_16x16x32_bf16 v[36:39], v[124:127], v[20:23], v[36:39]
  s_cmp_lg_u32 s32, 0
  s_cbranch_scc1 L_nospec
  v_lshlrev_b32 v3, 4, v2
  buffer_load_dwordx4 v[60:63], v3, s[28:31], s51 offen sc1
  s_waitcnt vmcnt(2)
  v_mfma_f32_16x16x32_bf16 v[24:27], v[140:143], v[128:131], v[24:27]
  v_mfma_f32_16x16x32_bf16 v[28:31], v[140:143], v[132:135], v[28:31]
  v_mfma_f32_16x16x32_bf16 v[32:35], v[140:143], v[136:139], v[32:35]
  v_mfma_f32_16x16x32_bf16 v[36:39], v[140:143], v[20:23], v[36:39]
  s_branch L_flush
L_nospec:
  s_waitcnt vmcnt(0)
  v_mfma_f32_16x16x32_bf16 v[24:27], v[140:143], v[128:131], v[24:27]
  v_mfma_f32_16x16x32_bf16 v[28:31], v[140:143], v[132:135], v[28:31]
  v_mfma_f32_16x16x32_bf16 v[32:35], v[140:143], v[136:139], v[32:35]
  v_mfma_f32_16x16x32_bf16 v[36:39], v[140:143], v[20:23], v[36:39]
L_flush:
  s_nop 7
  s_mov_b64 exec, s[56:57]
  ds_write_b128 v10, v[24:27] offset:0
  ds_write_b128 v10, v[28:31] offset:256
  ds_write_b128 v10, v[32:35] offset:512
  ds_write_b32 v11, v36 offset:768
  s_mov_b64 exec, -1
  s_waitcnt lgkmcnt(0)
  s_barrier
  s_cmp_lg_u32 s32, 0
  s_cbranch_scc1 L_end
  v_min_u32 v4, 47, v2
  v_lshlrev_b32 v4, 4, v4
  v_mov_b32 v3, 0
  ds_read_b32 v64, v3 offset:8960
  ds_read_b32 v65, v3 offset:9760
  ds_read_b32 v66, v3 offset:10560
  ds_read_b32 v67, v3 offset:11360
  ds_read_b32 v68, v3 offset:12160
  ds_read_b32 v69, v3 offset:12960
  ds_read_b32 v70, v3 offset:13760
  ds_read_b32 v71, v3 offset:14560
  ds_read_b128 v[72:75], v4 offset:8192
  ds_read_b128 v[76:79], v4 offset:8992
  ds_read_b128 v[80:83], v4 offset:9792
  ds_read_b128 v[84:87], v4 offset:10592
  ds_read_b128 v[88:91], v4 offset:11392
  ds_read_b128 v[92:95], v4 offset:12192
  ds_read_b128 v[96:99], v4 offset:12992
  ds_read_b128 v[100:103], v4 offset:13792
  s_waitcnt lgkmcnt(8)
  v_add_f32 v8, v64, v65
  v_add_f32 v8, v8, v66
  v_add_f32 v8, v8, v67
  v_add_f32 v8, v8, v68
  v_add_f32 v8, v8, v69
  v_add_f32 v8, v8, v70
  v_add_f32 v8, v8, v71
  s_waitcnt lgkmcnt(0)
  v_add_f32 v24, v72, v76
  v_add_f32 v25, v73, v77
  v_add_f32 v26, v74, v78
  v_add_f32 v27, v75, v79
  v_add_f32 v24, v24, v80
  v_add_f32 v25, v25, v81
  v_add_f32 v26, v26, v82
  v_add_f32 v27, v27, v83
  v_add_f32 v24, v24, v84
  v_add_f32 v25, v25, v85
  v_add_f32 v26, v26, v86
  v_add_f32 v27, v27, v87
  v_add_f32 v24, v24, v88
  v_add_f32 v25, v25, v89
  v_add_f32 v26, v26, v90
  v_add_f32 v27, v27, v91
  v_add_f32 v24, v24, v92
  v_add_f32 v25, v25, v93
  v_add_f32 v26, v26, v94
  v_add_f32 v27, v27, v95
  v_add_f32 v24, v24, v96
  v_add_f32 v25, v25, v97
  v_add_f32 v26, v26, v98
  v_add_f32 v27, v27, v99
  v_add_f32 v24, v24, v100
  v_add_f32 v25, v25, v101
  v_add_f32 v26, v26, v102
  v_add_f32 v27, v27, v103
  s_waitcnt vmcnt(0)
  v_readfirstlane_b32 s54, v14
  s_xor_b32 s53, s53, 8
  s_nop 2
  s_lshr_b32 s54, s54, s53
  s_and_b32 s54, s54, 0xff
  s_cmp_lg_u32 s54, 0
  s_cbranch_scc1 L_check
  v_cmp_eq_u32 vcc, 48, v2
  v_and_b32 v75, 0xffffff00, v27
  v_lshlrev_b32 v3, 4, v2
  v_cndmask_b32 v72, v24, v7, vcc
  v_cndmask_b32 v73, v25, v8, vcc
  v_mov_b32 v74, v26
  v_and_b32 v73, 0xffffff00, v73
  v_or_b32 v75, s52, v75
  v_or_b32 v73, s52, v73
  s_mov_b64 exec, s[48:49]
  buffer_store_dwordx4 v[72:75], v3, s[28:31], s50 offen sc1
  s_mov_b64 exec, -1
  s_branch L_fin
L_check:
  v_and_b32 v5, 0xff, v63
  v_and_b32 v6, 0xff, v61
  v_cmp_ne_u32 vcc, s54, v5
  v_cmp_ne_u32 s[58:59], s54, v6
  s_nop 1
  s_or_b64 vcc, vcc, s[58:59]
  s_and_b64 vcc, vcc, s[48:49]
  s_cbranch_scc0 L_valid
  v_lshlrev_b32 v3, 4, v2
  buffer_load_dwordx4 v[60:63], v3, s[28:31], s51 offen sc1
  s_waitcnt vmcnt(0)
  s_branch L_check
L_valid:
  v_readlane_b32 s58, v60, 48
  v_readlane_b32 s59, v61, 48
  s_nop 1
  v_max_f32 v3, s58, v7
  v_sub_f32 v4, v7, v3
  v_sub_f32 v5, s58, v3
  v_mul_f32 v4, s40, v4
  v_mul_f32 v5, s40, v5
  v_exp_f32 v4, v4
  v_exp_f32 v5, v5
  s_nop 0
  v_mul_f32 v8, v4, v8
  v_mul_f32 v24, v4, v24
  v_mul_f32 v25, v4, v25
  v_mul_f32 v26, v4, v26
  v_mul_f32 v27, v4, v27
  v_fmac_f32 v8, s59, v5
  v_fmac_f32 v24, v5, v60
  v_fmac_f32 v25, v5, v61
  v_fmac_f32 v26, v5, v62
  v_fmac_f32 v27, v5, v63
  v_rcp_f32 v8, v8
  s_nop 0
  v_mul_f32 v24, v24, v8
  v_mul_f32 v25, v25, v8
  v_mul_f32 v26, v26, v8
  v_mul_f32 v27, v27, v8
  v_cvt_pk_bf16_f32 v28, v24, v25
  v_cvt_pk_bf16_f32 v29, v26, v27
  v_lshlrev_b32 v5, 3, v2
  v_cmp_gt_u32 vcc, 48, v2
  s_and_saveexec_b64 s[48:49], vcc
  buffer_store_dwordx2 v[28:29], v5, s[20:23], s45 offen
  s_mov_b64 exec, s[48:49]
L_fin:
L_end:
  s_endpgm
.section .rodata,"a"
.p2align 6
.amdhsa_kernel standalone__softmax_full_bidir__decode_kernel
  .amdhsa_next_free_vgpr 144
  .amdhsa_next_free_sgpr 60
  .amdhsa_accum_offset 144
  .amdhsa_group_segment_fixed_size 0
  .amdhsa_kernarg_size 48
  .amdhsa_user_sgpr_count 2
  .amdhsa_user_sgpr_kernarg_segment_ptr 1
  .amdhsa_system_sgpr_workgroup_id_x 1
.end_amdhsa_kernel
```
